```python
import torch

def _softmax(x, axis=-1):
    return torch.softmax(x, dim=axis)
def _gelu(x):
    return torch.nn.functional.gelu(x, approximate="tanh")
def _silu(x):
    return torch.nn.functional.silu(x)
def _sigmoid(x):
    return torch.sigmoid(x)
def _layernorm(x, axis=-1, eps=1e-5):
    m = x.mean(dim=axis, keepdim=True)
    v = x.var(dim=axis, keepdim=True, unbiased=False)
    return (x - m) / torch.sqrt(v + eps)
def _scatter_add(tgt, idx, src, axis=0):
    return tgt.clone().index_add_(axis, idx, src)
def _segment_sum(src, seg, n):
    out = torch.zeros((n,) + src.shape[1:], dtype=src.dtype)
    return out.index_add_(0, seg, src)
def _pad(x, pw):
    flat = tuple(v for pair in reversed(pw) for v in pair)
    return torch.nn.functional.pad(x, flat)

kernel_name = 'recurrent_scan__sliding_block_cached__mixer_token_mlp__decode'

def setup_inputs():

    _w = (lambda a: (lambda t: t.to(torch.bfloat16) if t.is_floating_point() else t)(torch.as_tensor(a)))
    def _A_setup():
        B, Sq, D = 1, 1, 512
        Hq, Hkv, Sk, Dh = 32, 8, 32768, 128
        assert Hq % Hkv == 0, (Hq, Hkv)
        return {
            "x": _w((lambda *s: torch.randn(*s, dtype=torch.bfloat16) * 0.4)(B, Sq, D)),
            "k_cache": _w((lambda *s: torch.randn(*s, dtype=torch.bfloat16) * 1.6)(B, Hkv, Sk, Dh)),
            "v_cache": _w((lambda *s: torch.randn(*s, dtype=torch.bfloat16) * 1.6)(B, Hkv, Sk, Dh)),
            "wq": _w((lambda *s: torch.randn(*s, dtype=torch.bfloat16) * 1.6)(D, Hq * Dh) * (D ** -0.5)),
            "wo": _w((lambda *s: torch.randn(*s, dtype=torch.bfloat16) * 1.6)(Hq * Dh, D) * ((Hq * Dh) ** -0.5)),
        }
    _A_in = _A_setup()

    def _B_setup():
        B, S, D, F = 1, 1, 512, 1792
        return {
            "x": _w((lambda *s: torch.randn(*s, dtype=torch.bfloat16) * 0.4)(B, S, D)),
            "w1": _w((lambda *s: torch.randn(*s, dtype=torch.bfloat16) * 1.6)(S, F) * (S ** -0.5)),
            "b1": _w((lambda *s: torch.randn(*s, dtype=torch.bfloat16) * 1.6)(F) * 0.02),
            "w2": _w((lambda *s: torch.randn(*s, dtype=torch.bfloat16) * 1.6)(F, S) * (F ** -0.5)),
            "b2": _w((lambda *s: torch.randn(*s, dtype=torch.bfloat16) * 1.6)(S) * 0.02),
        }
    _B_in = _B_setup()

    return {
        "A_x": _A_in["x"],
        "A_k_cache": _A_in["k_cache"],
        "A_v_cache": _A_in["v_cache"],
        "A_wq": _A_in["wq"],
        "A_wo": _A_in["wo"],
        "B_x": _B_in["x"],
        "B_w1": _B_in["w1"],
        "B_b1": _B_in["b1"],
        "B_w2": _B_in["w2"],
        "B_b2": _B_in["b2"],
    }

def reference(A_x, A_k_cache, A_v_cache, A_wq, A_wo, B_x, B_w1, B_b1, B_w2, B_b2):
    def _A_ref(x, k_cache, v_cache, wq, wo):
        B, Sq, D = x.shape
        Hq, Dh = 32, 128
        Hkv, Sk = k_cache.shape[1], k_cache.shape[2]
        W = min(4096, max(256, Sk // 4))
        rep = Hq // Hkv
        q = (lambda x, *d: x.permute(*d))((x @ wq).reshape(B, Sq, Hq, Dh), 0, 2, 1, 3)
        k = (lambda x, n, axis: torch.repeat_interleave(x, n, dim=axis))(k_cache[:, :, Sk - W:, :], rep, axis=1)
        v = (lambda x, n, axis: torch.repeat_interleave(x, n, dim=axis))(v_cache[:, :, Sk - W:, :], rep, axis=1)
        scores = torch.einsum("bhqd,bhkd->bhqk", q, k) * (Dh ** -0.5)
        p = _softmax(scores, axis=-1)
        o = torch.einsum("bhqk,bhkd->bhqd", p, v)
        return (lambda x, *d: x.permute(*d))(o, 0, 2, 1, 3).reshape(B, Sq, Hq * Dh) @ wo

    def _B_ref(x, w1, b1, w2, b2):
        B, S, D = x.shape
        h = _layernorm(x, axis=-1)
        u = torch.einsum("bsd,sf->bdf", h, w1) + b1
        u = _gelu(u)
        y = torch.einsum("bdf,fs->bds", u, w2) + b2
        return (lambda x, *d: x.permute(*d))(y, 0, 2, 1)

    x = A_x
    xn = _layernorm(x, axis=-1)
    s = _A_ref(xn, A_k_cache, A_v_cache, A_wq, A_wo)
    g = _silu(_B_ref(xn, B_w1, B_b1, B_w2, B_b2))
    return x + s * g
```

```asm
; @launch grid=(256,1,1) block=(512,1,1) lds=112640
.amdgcn_target "amdgcn-amd-amdhsa--gfx950"
.text
.globl recurrent_scan__sliding_block_cached__mixer_token_mlp__decode_kernel
.p2align 8
.type recurrent_scan__sliding_block_cached__mixer_token_mlp__decode_kernel,@function
recurrent_scan__sliding_block_cached__mixer_token_mlp__decode_kernel:
L_start:
    s_getpc_b64 s[88:89]
    s_cmp_ge_u32 s2, 256
    s_cbranch_scc1 L_end
    s_load_dwordx16 s[16:31], s[0:1], 0
    s_load_dwordx8 s[32:39], s[0:1], 64
    s_load_dwordx2 s[40:41], s[0:1], 96
    s_lshr_b32 s13, s2, 3
    s_lshl_b32 s13, s13, 8
    v_lshl_add_u32 v35, v0, 7, s13
    v_cmp_gt_u32 vcc, 2, v0
    v_min_u32 v35, L_codeend-L_start-8, v35
    s_and_saveexec_b64 s[90:91], vcc
    s_cbranch_execz L_noepf
    global_load_dword v35, v35, s[88:89]
L_noepf:
    s_mov_b64 exec, -1
    v_lshrrev_b32 v4, 6, v0
    v_and_b32 v1, 63, v0
    v_readfirstlane_b32 s3, v4
    v_lshrrev_b32 v2, 4, v1
    v_and_b32 v3, 15, v1
    s_and_b32 s4, s2, 7
    s_lshr_b32 s5, s2, 3
    s_mov_b32 s12, 0x40000
    s_cmp_ge_u32 s3, 4
    s_cbranch_scc1 L_A
    v_lshlrev_b32 v4, 4, v1
    s_lshl_b32 s6, s4, 5
    s_add_u32 s6, s6, s5
    s_lshl_b32 s6, s6, 2
    s_cmp_lg_u32 s3, 0
    s_cbranch_scc1 L_B0
    s_setprio 3
    v_lshrrev_b32 v5, 3, v1
    v_lshlrev_b32 v6, 1, v2
    v_xor_b32 v6, v6, v1
    v_and_b32 v6, 7, v6
    v_lshlrev_b32 v5, 13, v5
    v_lshl_add_u32 v5, v6, 4, v5
    s_and_b32 s15, s5, 3
    s_lshl_b32 s15, s15, 20
    s_lshl_b32 s13, s4, 10
    s_add_u32 s15, s15, s13
    s_lshr_b32 s13, s5, 2
    s_lshl_b32 s13, s13, 7
    s_add_u32 s15, s15, s13
    s_mov_b32 m0, 79360
    s_mov_b32 s50, 0x00400000
    s_mov_b32 s51, 0x00020000
    s_mov_b32 s65, 16
    v_mov_b32 v22, 0
    s_waitcnt lgkmcnt(0)
    s_mov_b64 s[48:49], s[22:23]
    global_load_dwordx4 v[8:11], v4, s[16:17]
    global_load_dword v22, v22, s[40:41] offset:0 sc1
L_wqloop:
    buffer_load_dwordx4 v5, s[48:51], s15 offen nt lds
    s_sub_u32 s65, s65, 1
    s_add_u32 m0, m0, 1024
    s_add_u32 s15, s15, 65536
    s_cmp_lg_u32 s65, 0
    s_cbranch_scc1 L_wqloop
    s_barrier
    s_mov_b64 s[60:61], s[40:41]
    s_mov_b32 s62, 0x00300000
    s_mov_b32 s63, 0x00020000
    v_lshrrev_b32 v4, 1, v3
    v_lshlrev_b32 v4, 7, v4
    v_lshl_add_u32 v4, v2, 5, v4
    v_and_b32 v5, 1, v3
    v_lshl_add_u32 v7, v5, 4, v4
    s_lshl_b32 s15, s6, 7
    s_add_u32 s15, s15, 131072
    s_mov_b32 s78, 0x00ff00ff
    s_mov_b32 s79, 0x00ff00ff
    v_lshrrev_b32 v23, 2, v1
    v_lshlrev_b32 v23, 6, v23
    v_lshl_add_u32 v23, v5, 5, v23
    v_bfe_u32 v4, v1, 1, 1
    v_lshl_add_u32 v23, v4, 3, v23
    v_lshlrev_b32 v4, 4, v1
    s_mov_b32 exec_hi, 0
    buffer_load_dwordx4 v[28:31], v4, s[60:63], s15 offen nt
    s_mov_b64 exec, -1
    s_waitcnt vmcnt(17)
    s_branch L_ln1
L_A:
    s_sub_u32 s66, s3, 4
    v_lshlrev_b32 v7, 2, v2
    v_xor_b32 v7, v7, v3
    v_lshlrev_b32 v7, 4, v7
    v_lshl_add_u32 v7, v2, 8, v7
    s_lshl_b32 s15, s4, 23
    s_lshl_b32 s13, s5, 15
    s_add_u32 s15, s15, s13
    s_lshl_b32 s13, s66, 13
    s_add_u32 s15, s15, s13
    s_add_u32 s15, s15, 7340032
    s_mul_i32 s14, s66, 8320
    s_add_u32 s14, s14, 12288
    s_mov_b32 m0, s14
    s_mov_b32 s86, 0x20000
    s_mov_b32 s85, s15
    s_mov_b32 s65, 4
    s_mov_b32 s46, 0x04000000
    s_mov_b32 s47, 0x00020000
    s_waitcnt lgkmcnt(0)
    s_mov_b64 s[44:45], s[18:19]
    s_barrier
    s_add_u32 s96, s5, s66
    s_add_u32 s96, s96, s4
    s_mov_b32 s97, s14
L_kloop:
    s_and_b32 s96, s96, 7
    s_mul_i32 s87, s96, 1040
    s_add_u32 m0, s87, s97
    s_lshl_b32 s87, s96, 10
    s_add_u32 s87, s87, s15
    s_add_u32 s96, s96, 1
    buffer_load_dwordx4 v7, s[44:47], s87 offen nt lds
    s_sub_u32 s65, s65, 1
    s_cmp_lg_u32 s65, 0
    s_cbranch_scc1 L_kloop
    s_branch L_A2
L_B0:
    v_subrev_u32 v5, 64, v0
    v_lshlrev_b32 v6, 2, v5
    v_lshlrev_b32 v5, 4, v5
    v_mov_b32 v33, s6
    v_mov_b32 v34, 0
    s_waitcnt lgkmcnt(0)
    s_cmp_lg_u32 s3, 1
    s_cbranch_scc1 L_nox
    global_load_dwordx4 v[8:11], v4, s[16:17]
    global_load_dword v33, v33, s[16:17]
    global_load_ushort v34, v34, s[34:35]
L_nox:
    s_mov_b64 s[44:45], s[28:29]
    s_mov_b32 s46, 0x00000e00
    s_mov_b32 s47, 0x00020000
    s_mov_b64 s[48:49], s[30:31]
    s_mov_b32 s50, 0x00000e00
    s_mov_b32 s51, 0x00020000
    s_mov_b64 s[52:53], s[32:33]
    s_mov_b32 s54, 0x00000e00
    s_mov_b32 s55, 0x00020000
    s_mov_b64 s[60:61], s[40:41]
    s_mov_b32 s62, 0x00300000
    s_mov_b32 s63, 0x00020000
    v_mov_b32 v7, 0
    buffer_load_dwordx4 v[16:19], v5, s[44:47], 0 offen
    buffer_load_dword v20, v6, s[44:47], 0 offen offset:3072
    buffer_load_dwordx4 v[22:25], v5, s[48:51], 0 offen
    buffer_load_dword v26, v6, s[48:51], 0 offen offset:3072
    buffer_load_dwordx4 v[28:31], v5, s[52:55], 0 offen
    buffer_load_dword v32, v6, s[52:55], 0 offen offset:3072
    s_barrier
    s_cmp_lg_u32 s3, 1
    s_cbranch_scc1 L_B2
    s_waitcnt vmcnt(6)
L_ln1:
    v_lshlrev_b32 v36, 16, v8
    v_and_b32 v37, 0xffff0000, v8
    v_lshlrev_b32 v38, 16, v9
    v_and_b32 v39, 0xffff0000, v9
    v_lshlrev_b32 v40, 16, v10
    v_and_b32 v41, 0xffff0000, v10
    v_lshlrev_b32 v42, 16, v11
    v_and_b32 v43, 0xffff0000, v11
    v_readfirstlane_b32 s7, v36
    s_nop 1
    v_subrev_f32 v44, s7, v36
    v_subrev_f32 v45, s7, v37
    v_subrev_f32 v46, s7, v38
    v_subrev_f32 v47, s7, v39
    v_subrev_f32 v48, s7, v40
    v_subrev_f32 v49, s7, v41
    v_subrev_f32 v50, s7, v42
    v_subrev_f32 v51, s7, v43
    v_add_f32 v52, v44, v45
    v_mul_f32 v53, v44, v44
    v_fmac_f32 v53, v45, v45
    v_add_f32 v52, v52, v46
    v_fmac_f32 v53, v46, v46
    v_add_f32 v52, v52, v47
    v_fmac_f32 v53, v47, v47
    v_add_f32 v52, v52, v48
    v_fmac_f32 v53, v48, v48
    v_add_f32 v52, v52, v49
    v_fmac_f32 v53, v49, v49
    v_add_f32 v52, v52, v50
    v_fmac_f32 v53, v50, v50
    v_add_f32 v52, v52, v51
    v_fmac_f32 v53, v51, v51
    s_nop 0
    v_add_f32_dpp v52, v52, v52 row_ror:8 row_mask:0xf bank_mask:0xf
    v_add_f32_dpp v53, v53, v53 row_ror:8 row_mask:0xf bank_mask:0xf
    s_nop 0
    v_add_f32_dpp v52, v52, v52 row_ror:4 row_mask:0xf bank_mask:0xf
    v_add_f32_dpp v53, v53, v53 row_ror:4 row_mask:0xf bank_mask:0xf
    s_nop 0
    v_add_f32_dpp v52, v52, v52 row_ror:2 row_mask:0xf bank_mask:0xf
    v_add_f32_dpp v53, v53, v53 row_ror:2 row_mask:0xf bank_mask:0xf
    s_nop 0
    v_add_f32_dpp v52, v52, v52 row_ror:1 row_mask:0xf bank_mask:0xf
    v_add_f32_dpp v53, v53, v53 row_ror:1 row_mask:0xf bank_mask:0xf
    s_nop 0
    v_add_f32_dpp v52, v52, v52 row_bcast:15 row_mask:0xa bank_mask:0xf
    v_add_f32_dpp v53, v53, v53 row_bcast:15 row_mask:0xa bank_mask:0xf
    s_nop 0
    v_add_f32_dpp v52, v52, v52 row_bcast:31 row_mask:0xc bank_mask:0xf
    v_add_f32_dpp v53, v53, v53 row_bcast:31 row_mask:0xc bank_mask:0xf
    s_nop 0
    v_readlane_b32 s8, v52, 63
    v_readlane_b32 s9, v53, 63
    v_mov_b32 v4, 0x3b000000
    s_nop 0
    v_mul_f32 v54, s8, v4
    v_mul_f32 v55, s9, v4
    v_fma_f32 v55, -v54, v54, v55
    v_add_f32 v54, s7, v54
    v_max_f32 v55, 0, v55
    v_cvt_pk_bf16_f32 v54, v54, v54
    v_and_b32 v54, 0xffff0000, v54
    v_cvt_pk_bf16_f32 v55, v55, v55
    v_and_b32 v55, 0xffff0000, v55
    v_add_f32 v55, 0x3727c5ac, v55
    v_cvt_pk_bf16_f32 v55, v55, v55
    v_and_b32 v55, 0xffff0000, v55
    v_sqrt_f32 v55, v55
    s_nop 0
    v_cvt_pk_bf16_f32 v55, v55, v55
    v_and_b32 v55, 0xffff0000, v55
    v_rcp_f32 v55, v55
    s_nop 0
    v_sub_f32 v44, v36, v54
    v_sub_f32 v45, v37, v54
    v_sub_f32 v46, v38, v54
    v_sub_f32 v47, v39, v54
    v_sub_f32 v48, v40, v54
    v_sub_f32 v49, v41, v54
    v_sub_f32 v50, v42, v54
    v_sub_f32 v51, v43, v54
    v_cvt_pk_bf16_f32 v56, v44, v45
    v_cvt_pk_bf16_f32 v57, v46, v47
    v_cvt_pk_bf16_f32 v58, v48, v49
    v_cvt_pk_bf16_f32 v59, v50, v51
    v_lshlrev_b32 v44, 16, v56
    v_and_b32 v45, 0xffff0000, v56
    v_lshlrev_b32 v46, 16, v57
    v_and_b32 v47, 0xffff0000, v57
    v_lshlrev_b32 v48, 16, v58
    v_and_b32 v49, 0xffff0000, v58
    v_lshlrev_b32 v50, 16, v59
    v_and_b32 v51, 0xffff0000, v59
    v_mul_f32 v44, v44, v55
    v_mul_f32 v45, v45, v55
    v_mul_f32 v46, v46, v55
    v_mul_f32 v47, v47, v55
    v_mul_f32 v48, v48, v55
    v_mul_f32 v49, v49, v55
    v_mul_f32 v50, v50, v55
    v_mul_f32 v51, v51, v55
    v_cvt_pk_bf16_f32 v56, v44, v45
    v_cvt_pk_bf16_f32 v57, v46, v47
    v_cvt_pk_bf16_f32 v58, v48, v49
    v_cvt_pk_bf16_f32 v59, v50, v51
    s_cmp_lg_u32 s3, 0
    s_cbranch_scc1 L_B1
    ds_write2_b64 v23, v[56:57], v[58:59] offset0:0 offset1:2
    s_and_b32 s13, s5, 3
    s_lshl_b32 s13, s13, 8
    v_lshl_add_u32 v4, v2, 4, s13
    v_lshrrev_b32 v5, 2, v1
    v_lshlrev_b32 v5, 7, v5
    v_bfe_u32 v6, v1, 3, 2
    v_lshl_add_u32 v5, v6, 5, v5
    v_and_b32 v6, 3, v1
    v_lshl_add_u32 v5, v6, 3, v5
    v_add_u32 v60, 79360, v5
    v_xor_b32 v61, 32, v60
    v_xor_b32 v62, 64, v60
    v_xor_b32 v63, 96, v60
    s_waitcnt lgkmcnt(0)
    ds_read_b128 v[64:67], v4 offset:0
    ds_read_b128 v[68:71], v4 offset:64
    ds_read_b128 v[72:75], v4 offset:128
    ds_read_b128 v[76:79], v4 offset:192
    v_readfirstlane_b32 s42, v22
    s_mul_i32 s10, s42, 0x9E3779B1
    s_add_u32 s10, s10, 0x632BE5AB
    s_getreg_b32 s11, hwreg(HW_REG_XCC_ID, 0, 4)
    v_mov_b32 v14, s10
    v_mov_b32 v15, s11
    s_mov_b32 s72, 0xaaaaaaaa
    s_mov_b32 s73, 0xaaaaaaaa
    s_mov_b32 s74, 0xcccccccc
    s_mov_b32 s75, 0xcccccccc
    s_mov_b32 s76, 0xf0f0f0f0
    s_mov_b32 s77, 0xf0f0f0f0
    s_waitcnt vmcnt(13)
    ds_read_b64_tr_b16 v[80:81], v60 offset:0
    ds_read_b64_tr_b16 v[82:83], v60 offset:2048
    ds_read_b64_tr_b16 v[84:85], v61 offset:0
    ds_read_b64_tr_b16 v[86:87], v61 offset:2048
    ds_read_b64_tr_b16 v[88:89], v62 offset:0
    ds_read_b64_tr_b16 v[90:91], v62 offset:2048
    ds_read_b64_tr_b16 v[92:93], v63 offset:0
    ds_read_b64_tr_b16 v[94:95], v63 offset:2048
    s_waitcnt vmcnt(9)
    ds_read_b64_tr_b16 v[96:97], v60 offset:4096
    ds_read_b64_tr_b16 v[98:99], v60 offset:6144
    ds_read_b64_tr_b16 v[100:101], v61 offset:4096
    ds_read_b64_tr_b16 v[102:103], v61 offset:6144
    ds_read_b64_tr_b16 v[104:105], v62 offset:4096
    ds_read_b64_tr_b16 v[106:107], v62 offset:6144
    ds_read_b64_tr_b16 v[108:109], v63 offset:4096
    ds_read_b64_tr_b16 v[110:111], v63 offset:6144
    s_waitcnt lgkmcnt(14)
    v_mfma_f32_16x16x32_bf16 v[144:147], v[80:83], v[64:67], 0
    s_waitcnt lgkmcnt(12)
    v_mfma_f32_16x16x32_bf16 v[148:151], v[84:87], v[64:67], 0
    s_waitcnt lgkmcnt(10)
    v_mfma_f32_16x16x32_bf16 v[152:155], v[88:91], v[64:67], 0
    s_waitcnt lgkmcnt(8)
    v_mfma_f32_16x16x32_bf16 v[156:159], v[92:95], v[64:67], 0
    s_waitcnt vmcnt(5)
    ds_read_b64_tr_b16 v[112:113], v60 offset:8192
    ds_read_b64_tr_b16 v[114:115], v60 offset:10240
    ds_read_b64_tr_b16 v[116:117], v61 offset:8192
    ds_read_b64_tr_b16 v[118:119], v61 offset:10240
    ds_read_b64_tr_b16 v[120:121], v62 offset:8192
    ds_read_b64_tr_b16 v[122:123], v62 offset:10240
    ds_read_b64_tr_b16 v[124:125], v63 offset:8192
    ds_read_b64_tr_b16 v[126:127], v63 offset:10240
    s_waitcnt lgkmcnt(14)
    v_mfma_f32_16x16x32_bf16 v[144:147], v[96:99], v[68:71], v[144:147]
    s_waitcnt lgkmcnt(12)
    v_mfma_f32_16x16x32_bf16 v[148:151], v[100:103], v[68:71], v[148:151]
    s_waitcnt lgkmcnt(10)
    v_mfma_f32_16x16x32_bf16 v[152:155], v[104:107], v[68:71], v[152:155]
    s_waitcnt lgkmcnt(8)
    v_mfma_f32_16x16x32_bf16 v[156:159], v[108:111], v[68:71], v[156:159]
    s_waitcnt vmcnt(1)
    ds_read_b64_tr_b16 v[128:129], v60 offset:12288
    ds_read_b64_tr_b16 v[130:131], v60 offset:14336
    ds_read_b64_tr_b16 v[132:133], v61 offset:12288
    ds_read_b64_tr_b16 v[134:135], v61 offset:14336
    ds_read_b64_tr_b16 v[136:137], v62 offset:12288
    ds_read_b64_tr_b16 v[138:139], v62 offset:14336
    ds_read_b64_tr_b16 v[140:141], v63 offset:12288
    ds_read_b64_tr_b16 v[142:143], v63 offset:14336
    s_waitcnt lgkmcnt(14)
    v_mfma_f32_16x16x32_bf16 v[144:147], v[112:115], v[72:75], v[144:147]
    s_waitcnt lgkmcnt(12)
    v_mfma_f32_16x16x32_bf16 v[148:151], v[116:119], v[72:75], v[148:151]
    s_waitcnt lgkmcnt(10)
    v_mfma_f32_16x16x32_bf16 v[152:155], v[120:123], v[72:75], v[152:155]
    s_waitcnt lgkmcnt(8)
    v_mfma_f32_16x16x32_bf16 v[156:159], v[124:127], v[72:75], v[156:159]
    s_waitcnt lgkmcnt(6)
    v_mfma_f32_16x16x32_bf16 v[144:147], v[128:131], v[76:79], v[144:147]
    s_waitcnt lgkmcnt(4)
    v_mfma_f32_16x16x32_bf16 v[148:151], v[132:135], v[76:79], v[148:151]
    s_waitcnt lgkmcnt(2)
    v_mfma_f32_16x16x32_bf16 v[152:155], v[136:139], v[76:79], v[152:155]
    s_waitcnt lgkmcnt(0)
    v_mfma_f32_16x16x32_bf16 v[156:159], v[140:143], v[76:79], v[156:159]
    v_lshrrev_b32 v4, 3, v1
    v_and_b32 v5, 7, v1
    v_lshlrev_b32 v16, 11, v4
    v_lshl_add_u32 v16, v5, 4, v16
    s_nop 1
    v_cndmask_b32 v44, v144, v146, s[72:73]
    v_cndmask_b32 v45, v145, v147, s[72:73]
    v_cndmask_b32 v46, v148, v150, s[72:73]
    v_cndmask_b32 v47, v149, v151, s[72:73]
    v_cndmask_b32 v48, v152, v154, s[72:73]
    v_cndmask_b32 v49, v153, v155, s[72:73]
    v_cndmask_b32 v50, v156, v158, s[72:73]
    v_cndmask_b32 v51, v157, v159, s[72:73]
    v_cndmask_b32 v44, v44, v46, s[74:75]
    v_cndmask_b32 v45, v45, v47, s[74:75]
    v_cndmask_b32 v48, v48, v50, s[74:75]
    v_cndmask_b32 v49, v49, v51, s[74:75]
    v_cndmask_b32 v12, v44, v48, s[76:77]
    v_cndmask_b32 v13, v45, v49, s[76:77]
    s_mov_b64 exec, s[78:79]
    buffer_store_dwordx4 v[12:15], v7, s[60:63], s15 offen
    s_mov_b64 exec, -1
    s_barrier
    v_lshlrev_b32 v17, 7, v4
    v_lshl_add_u32 v17, v2, 4, v17
    v_lshl_add_u32 v17, v5, 2, v17
    v_add_u32 v17, 1024, v17
    s_lshl_b32 s84, s4, 14
    s_add_u32 s84, s84, 131072
    s_mov_b32 s65, 0
    s_mov_b32 s67, 1
    s_sleep 12
L_qpollA:
    buffer_load_dwordx4 v[80:83], v16, s[60:63], s84 offen offset:0 sc1
    buffer_load_dwordx4 v[84:87], v16, s[60:63], s84 offen offset:128 sc1
    buffer_load_dwordx4 v[88:91], v16, s[60:63], s84 offen offset:256 sc1
    buffer_load_dwordx4 v[92:95], v16, s[60:63], s84 offen offset:384 sc1
    buffer_load_dwordx4 v[96:99], v16, s[60:63], s84 offen offset:512 sc1
    buffer_load_dwordx4 v[100:103], v16, s[60:63], s84 offen offset:640 sc1
    buffer_load_dwordx4 v[104:107], v16, s[60:63], s84 offen offset:768 sc1
    buffer_load_dwordx4 v[108:111], v16, s[60:63], s84 offen offset:896 sc1
    buffer_load_dwordx4 v[112:115], v16, s[60:63], s84 offen offset:1024 sc1
    buffer_load_dwordx4 v[116:119], v16, s[60:63], s84 offen offset:1152 sc1
    buffer_load_dwordx4 v[120:123], v16, s[60:63], s84 offen offset:1280 sc1
    buffer_load_dwordx4 v[124:127], v16, s[60:63], s84 offen offset:1408 sc1
    buffer_load_dwordx4 v[128:131], v16, s[60:63], s84 offen offset:1536 sc1
    buffer_load_dwordx4 v[132:135], v16, s[60:63], s84 offen offset:1664 sc1
    buffer_load_dwordx4 v[136:139], v16, s[60:63], s84 offen offset:1792 sc1
    buffer_load_dwordx4 v[140:143], v16, s[60:63], s84 offen offset:1920 sc1
    s_waitcnt vmcnt(15)
    v_cmpx_eq_u64 vcc, s[10:11], v[82:83]
    s_waitcnt vmcnt(14)
    v_cmpx_eq_u64 vcc, s[10:11], v[86:87]
    s_waitcnt vmcnt(13)
    v_cmpx_eq_u64 vcc, s[10:11], v[90:91]
    s_waitcnt vmcnt(12)
    v_cmpx_eq_u64 vcc, s[10:11], v[94:95]
    s_waitcnt vmcnt(11)
    v_cmpx_eq_u64 vcc, s[10:11], v[98:99]
    v_add_f32 v24, v80, v96
    v_add_f32 v25, v81, v97
    s_waitcnt vmcnt(10)
    v_cmpx_eq_u64 vcc, s[10:11], v[102:103]
    v_add_f32 v26, v84, v100
    v_add_f32 v27, v85, v101
    s_waitcnt vmcnt(9)
    v_cmpx_eq_u64 vcc, s[10:11], v[106:107]
    v_add_f32 v28, v88, v104
    v_add_f32 v29, v89, v105
    s_waitcnt vmcnt(8)
    v_cmpx_eq_u64 vcc, s[10:11], v[110:111]
    v_add_f32 v30, v92, v108
    v_add_f32 v31, v93, v109
    s_waitcnt vmcnt(7)
    v_cmpx_eq_u64 vcc, s[10:11], v[114:115]
    v_add_f32 v24, v24, v112
    v_add_f32 v25, v25, v113
    s_waitcnt vmcnt(6)
    v_cmpx_eq_u64 vcc, s[10:11], v[118:119]
    v_add_f32 v26, v26, v116
    v_add_f32 v27, v27, v117
    s_waitcnt vmcnt(5)
    v_cmpx_eq_u64 vcc, s[10:11], v[122:123]
    v_add_f32 v28, v28, v120
    v_add_f32 v29, v29, v121
    s_waitcnt vmcnt(4)
    v_cmpx_eq_u64 vcc, s[10:11], v[126:127]
    v_add_f32 v30, v30, v124
    v_add_f32 v31, v31, v125
    s_waitcnt vmcnt(3)
    v_cmpx_eq_u64 vcc, s[10:11], v[130:131]
    v_add_f32 v24, v24, v128
    v_add_f32 v25, v25, v129
    s_waitcnt vmcnt(2)
    v_cmpx_eq_u64 vcc, s[10:11], v[134:135]
    v_add_f32 v26, v26, v132
    v_add_f32 v27, v27, v133
    s_waitcnt vmcnt(1)
    v_cmpx_eq_u64 vcc, s[10:11], v[138:139]
    v_add_f32 v28, v28, v136
    v_add_f32 v29, v29, v137
    s_waitcnt vmcnt(0)
    v_cmpx_eq_u64 vcc, s[10:11], v[142:143]
    v_add_f32 v30, v30, v140
    v_add_f32 v31, v31, v141
    s_cmp_eq_u64 exec, -1
    s_cbranch_scc0 L_qfail
L_qok:
    v_cvt_pk_bf16_f32 v44, v24, v25
    v_cvt_pk_bf16_f32 v45, v26, v27
    v_cvt_pk_bf16_f32 v46, v28, v29
    v_cvt_pk_bf16_f32 v47, v30, v31
    v_mov_b32 v48, s67
    v_mov_b32 v49, s10
    v_mov_b32 v50, 2112
    ds_write2_b32 v17, v44, v45 offset0:0 offset1:8
    ds_write2_b32 v17, v46, v47 offset0:16 offset1:24
    ds_write_b64 v50, v[48:49]
    s_waitcnt lgkmcnt(0)
    s_barrier
L_qb_done:
    s_barrier
    s_barrier
    s_barrier
    s_barrier
    v_mov_b32 v5, 0
    ds_read_b128 v[36:39], v5 offset:2432
    ds_read_b64 v[40:41], v5 offset:2448
    ds_read_b64 v[42:43], v5 offset:2136
    s_waitcnt lgkmcnt(0)
    v_lshlrev_b32 v20, 16, v42
    v_and_b32 v21, 0xffff0000, v42
    v_lshlrev_b32 v43, 16, v43
    v_add_f32 v18, v36, v38
    v_add_f32 v19, v37, v39
    v_add_f32 v18, v18, v40
    v_add_f32 v19, v19, v41
    v_cvt_pk_bf16_f32 v5, v18, v19
    v_lshlrev_b32 v18, 16, v5
    v_and_b32 v19, 0xffff0000, v5
    v_add_f32 v18, v43, v18
    v_add_f32 v19, v43, v19
    v_cvt_pk_bf16_f32 v5, v18, v19
    v_lshlrev_b32 v18, 16, v5
    v_and_b32 v19, 0xffff0000, v5
    v_mul_f32 v36, 0xbfb8aa3b, v18
    v_mul_f32 v37, 0xbfb8aa3b, v19
    v_exp_f32 v36, v36
    v_exp_f32 v37, v37
    s_nop 0
    v_add_f32 v36, 1.0, v36
    v_add_f32 v37, 1.0, v37
    v_rcp_f32 v36, v36
    v_rcp_f32 v37, v37
    s_nop 0
    v_mul_f32 v18, v18, v36
    v_mul_f32 v19, v19, v37
    v_cvt_pk_bf16_f32 v5, v18, v19
    v_lshlrev_b32 v18, 16, v5
    v_and_b32 v19, 0xffff0000, v5
    s_lshr_b32 s85, s6, 8
    s_lshl_b32 s85, s85, 16
    s_and_b32 s13, s6, 255
    s_lshl_b32 s13, s13, 2
    s_add_u32 s85, s85, s13
    s_add_u32 s85, s85, 393216
    v_lshlrev_b32 v5, 10, v1
    s_mov_b32 s82, s10
    s_mov_b64 s[44:45], s[36:37]
    s_mov_b32 s46, 0x00000400
    s_mov_b32 s47, 0x00020000
    v_mov_b32 v6, 0
    s_sleep 15
    s_mov_b32 s83, s10
L_h3loop:
    buffer_load_dwordx4 v[36:39], v5, s[60:63], s85 offen sc1
    s_waitcnt vmcnt(0)
    v_cmpx_ne_u64 vcc, s[82:83], v[38:39]
    s_cbranch_execz L_h3ok
    s_sub_u32 s12, s12, 1
    s_cbranch_scc0 L_h3loop
    s_branch L_end
L_h3ok:
    s_mov_b64 exec, -1
    s_nop 2
    s_nop 0
    v_add_f32_dpp v36, v36, v36 row_ror:8 row_mask:0xf bank_mask:0xf
    v_add_f32_dpp v37, v37, v37 row_ror:8 row_mask:0xf bank_mask:0xf
    s_nop 0
    v_add_f32_dpp v36, v36, v36 row_ror:4 row_mask:0xf bank_mask:0xf
    v_add_f32_dpp v37, v37, v37 row_ror:4 row_mask:0xf bank_mask:0xf
    s_nop 0
    v_add_f32_dpp v36, v36, v36 row_ror:2 row_mask:0xf bank_mask:0xf
    v_add_f32_dpp v37, v37, v37 row_ror:2 row_mask:0xf bank_mask:0xf
    s_nop 0
    v_add_f32_dpp v36, v36, v36 row_ror:1 row_mask:0xf bank_mask:0xf
    v_add_f32_dpp v37, v37, v37 row_ror:1 row_mask:0xf bank_mask:0xf
    s_nop 0
    v_add_f32_dpp v36, v36, v36 row_bcast:15 row_mask:0xa bank_mask:0xf
    v_add_f32_dpp v37, v37, v37 row_bcast:15 row_mask:0xa bank_mask:0xf
    s_nop 0
    v_add_f32_dpp v36, v36, v36 row_bcast:31 row_mask:0xc bank_mask:0xf
    v_add_f32_dpp v37, v37, v37 row_bcast:31 row_mask:0xc bank_mask:0xf
    v_cvt_pk_bf16_f32 v4, v36, v37
    v_lshlrev_b32 v36, 16, v4
    v_and_b32 v37, 0xffff0000, v4
    v_mul_f32 v36, v36, v18
    v_mul_f32 v37, v37, v19
    v_cvt_pk_bf16_f32 v4, v36, v37
    v_lshlrev_b32 v36, 16, v4
    v_and_b32 v37, 0xffff0000, v4
    v_add_f32 v36, v36, v20
    v_add_f32 v37, v37, v21
    v_cvt_pk_bf16_f32 v4, v36, v37
    s_mov_b32 exec_lo, 0
    s_mov_b32 exec_hi, 0x80000000
    buffer_store_dword v4, v6, s[44:47], s6 offen
    s_cmp_lg_u32 s2, 0
    s_cbranch_scc1 L_fin
    buffer_store_dword v14, v6, s[60:63], 0 offen offset:0 sc1
    s_branch L_fin
L_qfail:
    s_mov_b64 exec, -1
    s_sub_u32 s12, s12, 1
    s_cbranch_scc1 L_end
    s_and_b32 s13, s12, 3
    s_cmp_lg_u32 s13, 0
    s_cbranch_scc1 L_qpollA
    s_cmp_lg_u32 s65, 0
    s_cbranch_scc1 L_qpollB
    s_mov_b32 s65, 1
    s_add_u32 s15, s15, 131072
    s_mov_b64 exec, s[78:79]
    buffer_store_dwordx4 v[12:15], v7, s[60:63], s15 offen sc1
    s_mov_b64 exec, -1
L_qpollB:
    s_add_u32 s13, s84, 131072
    buffer_load_dwordx4 v[80:83], v16, s[60:63], s13 offen offset:0 sc1
    buffer_load_dwordx4 v[84:87], v16, s[60:63], s13 offen offset:128 sc1
    buffer_load_dwordx4 v[88:91], v16, s[60:63], s13 offen offset:256 sc1
    buffer_load_dwordx4 v[92:95], v16, s[60:63], s13 offen offset:384 sc1
    buffer_load_dwordx4 v[96:99], v16, s[60:63], s13 offen offset:512 sc1
    buffer_load_dwordx4 v[100:103], v16, s[60:63], s13 offen offset:640 sc1
    buffer_load_dwordx4 v[104:107], v16, s[60:63], s13 offen offset:768 sc1
    buffer_load_dwordx4 v[108:111], v16, s[60:63], s13 offen offset:896 sc1
    buffer_load_dwordx4 v[112:115], v16, s[60:63], s13 offen offset:1024 sc1
    buffer_load_dwordx4 v[116:119], v16, s[60:63], s13 offen offset:1152 sc1
    buffer_load_dwordx4 v[120:123], v16, s[60:63], s13 offen offset:1280 sc1
    buffer_load_dwordx4 v[124:127], v16, s[60:63], s13 offen offset:1408 sc1
    buffer_load_dwordx4 v[128:131], v16, s[60:63], s13 offen offset:1536 sc1
    buffer_load_dwordx4 v[132:135], v16, s[60:63], s13 offen offset:1664 sc1
    buffer_load_dwordx4 v[136:139], v16, s[60:63], s13 offen offset:1792 sc1
    buffer_load_dwordx4 v[140:143], v16, s[60:63], s13 offen offset:1920 sc1
    s_waitcnt vmcnt(0)
    v_cmpx_eq_u32 vcc, s10, v82
    v_cmpx_eq_u32 vcc, s10, v86
    v_cmpx_eq_u32 vcc, s10, v90
    v_cmpx_eq_u32 vcc, s10, v94
    v_cmpx_eq_u32 vcc, s10, v98
    v_cmpx_eq_u32 vcc, s10, v102
    v_cmpx_eq_u32 vcc, s10, v106
    v_cmpx_eq_u32 vcc, s10, v110
    v_cmpx_eq_u32 vcc, s10, v114
    v_cmpx_eq_u32 vcc, s10, v118
    v_cmpx_eq_u32 vcc, s10, v122
    v_cmpx_eq_u32 vcc, s10, v126
    v_cmpx_eq_u32 vcc, s10, v130
    v_cmpx_eq_u32 vcc, s10, v134
    v_cmpx_eq_u32 vcc, s10, v138
    v_cmpx_eq_u32 vcc, s10, v142
    s_cmp_eq_u64 exec, -1
    s_mov_b64 exec, -1
    s_cbranch_scc0 L_qpollA
    v_add_f32 v24, v80, v96
    v_add_f32 v25, v81, v97
    v_add_f32 v26, v84, v100
    v_add_f32 v27, v85, v101
    v_add_f32 v28, v88, v104
    v_add_f32 v29, v89, v105
    v_add_f32 v30, v92, v108
    v_add_f32 v31, v93, v109
    v_add_f32 v24, v24, v112
    v_add_f32 v25, v25, v113
    v_add_f32 v26, v26, v116
    v_add_f32 v27, v27, v117
    v_add_f32 v28, v28, v120
    v_add_f32 v29, v29, v121
    v_add_f32 v30, v30, v124
    v_add_f32 v31, v31, v125
    v_add_f32 v24, v24, v128
    v_add_f32 v25, v25, v129
    v_add_f32 v26, v26, v132
    v_add_f32 v27, v27, v133
    v_add_f32 v28, v28, v136
    v_add_f32 v29, v29, v137
    v_add_f32 v30, v30, v140
    v_add_f32 v31, v31, v141
    v_cmpx_eq_u32 vcc, s11, v83
    v_cmpx_eq_u32 vcc, s11, v87
    v_cmpx_eq_u32 vcc, s11, v91
    v_cmpx_eq_u32 vcc, s11, v95
    v_cmpx_eq_u32 vcc, s11, v99
    v_cmpx_eq_u32 vcc, s11, v103
    v_cmpx_eq_u32 vcc, s11, v107
    v_cmpx_eq_u32 vcc, s11, v111
    v_cmpx_eq_u32 vcc, s11, v115
    v_cmpx_eq_u32 vcc, s11, v119
    v_cmpx_eq_u32 vcc, s11, v123
    v_cmpx_eq_u32 vcc, s11, v127
    v_cmpx_eq_u32 vcc, s11, v131
    v_cmpx_eq_u32 vcc, s11, v135
    v_cmpx_eq_u32 vcc, s11, v139
    v_cmpx_eq_u32 vcc, s11, v143
    s_cmp_eq_u64 exec, -1
    s_cselect_b32 s67, 1, 0
    s_mov_b64 exec, -1
    s_branch L_qok
L_B1:
    v_lshlrev_b32 v44, 16, v56
    v_and_b32 v45, 0xffff0000, v56
    v_lshlrev_b32 v46, 16, v57
    v_and_b32 v47, 0xffff0000, v57
    v_lshlrev_b32 v48, 16, v58
    v_and_b32 v49, 0xffff0000, v58
    v_lshlrev_b32 v50, 16, v59
    v_and_b32 v51, 0xffff0000, v59
    v_add_f32 v52, v44, v45
    v_mul_f32 v53, v44, v44
    v_fmac_f32 v53, v45, v45
    v_add_f32 v52, v52, v46
    v_fmac_f32 v53, v46, v46
    v_add_f32 v52, v52, v47
    v_fmac_f32 v53, v47, v47
    v_add_f32 v52, v52, v48
    v_fmac_f32 v53, v48, v48
    v_add_f32 v52, v52, v49
    v_fmac_f32 v53, v49, v49
    v_add_f32 v52, v52, v50
    v_fmac_f32 v53, v50, v50
    v_add_f32 v52, v52, v51
    v_fmac_f32 v53, v51, v51
    s_nop 0
    v_add_f32_dpp v52, v52, v52 row_ror:8 row_mask:0xf bank_mask:0xf
    v_add_f32_dpp v53, v53, v53 row_ror:8 row_mask:0xf bank_mask:0xf
    s_nop 0
    v_add_f32_dpp v52, v52, v52 row_ror:4 row_mask:0xf bank_mask:0xf
    v_add_f32_dpp v53, v53, v53 row_ror:4 row_mask:0xf bank_mask:0xf
    s_nop 0
    v_add_f32_dpp v52, v52, v52 row_ror:2 row_mask:0xf bank_mask:0xf
    v_add_f32_dpp v53, v53, v53 row_ror:2 row_mask:0xf bank_mask:0xf
    s_nop 0
    v_add_f32_dpp v52, v52, v52 row_ror:1 row_mask:0xf bank_mask:0xf
    v_add_f32_dpp v53, v53, v53 row_ror:1 row_mask:0xf bank_mask:0xf
    s_nop 0
    v_add_f32_dpp v52, v52, v52 row_bcast:15 row_mask:0xa bank_mask:0xf
    v_add_f32_dpp v53, v53, v53 row_bcast:15 row_mask:0xa bank_mask:0xf
    s_nop 0
    v_add_f32_dpp v52, v52, v52 row_bcast:31 row_mask:0xc bank_mask:0xf
    v_add_f32_dpp v53, v53, v53 row_bcast:31 row_mask:0xc bank_mask:0xf
    s_nop 0
    v_readlane_b32 s8, v52, 63
    v_readlane_b32 s9, v53, 63
    v_lshlrev_b32 v44, 16, v33
    v_and_b32 v45, 0xffff0000, v33
    v_sub_f32 v44, v44, v54
    v_sub_f32 v45, v45, v54
    v_cvt_pk_bf16_f32 v4, v44, v45
    v_lshlrev_b32 v44, 16, v4
    v_and_b32 v45, 0xffff0000, v4
    v_mul_f32 v44, v44, v55
    v_mul_f32 v45, v45, v55
    v_cvt_pk_bf16_f32 v4, v44, v45
    v_lshlrev_b32 v44, 16, v4
    v_and_b32 v45, 0xffff0000, v4
    v_mov_b32 v4, 0x3b000000
    v_mul_f32 v54, s8, v4
    v_mul_f32 v55, s9, v4
    v_fma_f32 v55, -v54, v54, v55
    v_max_f32 v55, 0, v55
    v_cvt_pk_bf16_f32 v54, v54, v54
    v_and_b32 v54, 0xffff0000, v54
    v_cvt_pk_bf16_f32 v55, v55, v55
    v_and_b32 v55, 0xffff0000, v55
    v_add_f32 v55, 0x3727c5ac, v55
    v_cvt_pk_bf16_f32 v55, v55, v55
    v_and_b32 v55, 0xffff0000, v55
    v_sqrt_f32 v55, v55
    s_nop 0
    v_cvt_pk_bf16_f32 v55, v55, v55
    v_and_b32 v55, 0xffff0000, v55
    v_rcp_f32 v55, v55
    s_nop 0
    v_sub_f32 v44, v44, v54
    v_sub_f32 v45, v45, v54
    v_cvt_pk_bf16_f32 v4, v44, v45
    v_lshlrev_b32 v44, 16, v4
    v_and_b32 v45, 0xffff0000, v4
    v_mul_f32 v44, v44, v55
    v_mul_f32 v45, v45, v55
    v_cvt_pk_bf16_f32 v4, v44, v45
    v_lshlrev_b32 v44, 16, v4
    v_and_b32 v45, 0xffff0000, v4
    v_mov_b32 v4, 2128
    ds_write_b64 v4, v[44:45]
    ds_write2_b32 v4, v33, v34 offset0:2 offset1:3
    s_waitcnt lgkmcnt(0)
L_B2:
    v_mov_b32 v60, 0
    v_mov_b32 v61, 0
    v_mov_b32 v52, 0xc0135761
    s_mov_b32 s13, 0xbdd2d3e8
    s_mov_b32 s65, 5
    v_mov_b32 v4, 2128
    s_barrier
    ds_read_b64 v[44:45], v4
    s_waitcnt lgkmcnt(0)
    v_readfirstlane_b32 s80, v44
    v_readfirstlane_b32 s81, v45
    s_waitcnt vmcnt(0)
L_Bloop:
    v_lshlrev_b32 v36, 16, v16
    v_and_b32 v37, 0xffff0000, v16
    v_lshlrev_b32 v38, 16, v22
    v_and_b32 v39, 0xffff0000, v22
    v_mul_f32 v44, s80, v36
    v_mul_f32 v45, s80, v37
    v_mul_f32 v46, s81, v36
    v_mul_f32 v47, s81, v37
    v_cvt_pk_bf16_f32 v48, v44, v45
    v_cvt_pk_bf16_f32 v49, v46, v47
    v_lshlrev_b32 v44, 16, v48
    v_and_b32 v45, 0xffff0000, v48
    v_lshlrev_b32 v46, 16, v49
    v_and_b32 v47, 0xffff0000, v49
    v_add_f32 v44, v44, v38
    v_add_f32 v45, v45, v39
    v_add_f32 v46, v46, v38
    v_add_f32 v47, v47, v39
    v_cvt_pk_bf16_f32 v48, v44, v45
    v_cvt_pk_bf16_f32 v49, v46, v47
    v_lshlrev_b32 v44, 16, v48
    v_and_b32 v45, 0xffff0000, v48
    v_lshlrev_b32 v46, 16, v49
    v_and_b32 v47, 0xffff0000, v49
    v_mul_f32 v48, v44, v44
    v_mul_f32 v49, v45, v45
    v_mul_f32 v50, v46, v46
    v_mul_f32 v51, v47, v47
    v_fma_f32 v48, v48, s13, v52
    v_fma_f32 v49, v49, s13, v52
    v_fma_f32 v50, v50, s13, v52
    v_fma_f32 v51, v51, s13, v52
    v_mul_f32 v48, v48, v44
    v_mul_f32 v49, v49, v45
    v_mul_f32 v50, v50, v46
    v_mul_f32 v51, v51, v47
    v_exp_f32 v48, v48
    v_exp_f32 v49, v49
    v_exp_f32 v50, v50
    v_exp_f32 v51, v51
    v_add_f32 v48, 1.0, v48
    v_add_f32 v49, 1.0, v49
    v_add_f32 v50, 1.0, v50
    v_add_f32 v51, 1.0, v51
    v_rcp_f32 v48, v48
    v_rcp_f32 v49, v49
    v_rcp_f32 v50, v50
    v_rcp_f32 v51, v51
    v_mul_f32 v48, v48, v44
    v_mul_f32 v49, v49, v45
    v_mul_f32 v50, v50, v46
    v_mul_f32 v51, v51, v47
    v_cvt_pk_bf16_f32 v44, v48, v49
    v_cvt_pk_bf16_f32 v45, v50, v51
    v_dot2c_f32_bf16 v60, v44, v28
    v_dot2c_f32_bf16 v61, v45, v28
    v_mov_b32 v16, v17
    v_mov_b32 v17, v18
    v_mov_b32 v18, v19
    v_mov_b32 v19, v20
    v_mov_b32 v22, v23
    v_mov_b32 v23, v24
    v_mov_b32 v24, v25
    v_mov_b32 v25, v26
    v_mov_b32 v28, v29
    v_mov_b32 v29, v30
    v_mov_b32 v30, v31
    v_mov_b32 v31, v32
    s_sub_u32 s65, s65, 1
    s_cmp_lg_u32 s65, 0
    s_cbranch_scc1 L_Bloop
    s_nop 0
    v_add_f32_dpp v60, v60, v60 row_ror:8 row_mask:0xf bank_mask:0xf
    v_add_f32_dpp v61, v61, v61 row_ror:8 row_mask:0xf bank_mask:0xf
    s_nop 0
    v_add_f32_dpp v60, v60, v60 row_ror:4 row_mask:0xf bank_mask:0xf
    v_add_f32_dpp v61, v61, v61 row_ror:4 row_mask:0xf bank_mask:0xf
    s_nop 0
    v_add_f32_dpp v60, v60, v60 row_ror:2 row_mask:0xf bank_mask:0xf
    v_add_f32_dpp v61, v61, v61 row_ror:2 row_mask:0xf bank_mask:0xf
    s_nop 0
    v_add_f32_dpp v60, v60, v60 row_ror:1 row_mask:0xf bank_mask:0xf
    v_add_f32_dpp v61, v61, v61 row_ror:1 row_mask:0xf bank_mask:0xf
    s_nop 0
    v_add_f32_dpp v60, v60, v60 row_bcast:15 row_mask:0xa bank_mask:0xf
    v_add_f32_dpp v61, v61, v61 row_bcast:15 row_mask:0xa bank_mask:0xf
    s_nop 0
    v_add_f32_dpp v60, v60, v60 row_bcast:31 row_mask:0xc bank_mask:0xf
    v_add_f32_dpp v61, v61, v61 row_bcast:31 row_mask:0xc bank_mask:0xf
    s_lshl_b32 s13, s3, 3
    v_mov_b32 v4, s13
    s_mov_b32 exec_lo, 0
    s_mov_b32 exec_hi, 0x80000000
    ds_write_b64 v4, v[60:61] offset:2424
    s_mov_b64 exec, -1
    s_waitcnt lgkmcnt(0)
    s_endpgm
L_A2:
L_Aend1:
    s_mov_b64 s[48:49], s[20:21]
    s_mov_b32 s50, 0x04000000
    s_mov_b32 s51, 0x00020000
    s_mov_b64 s[60:61], s[40:41]
    s_mov_b32 s62, 0x00300000
    s_mov_b32 s63, 0x00020000
    s_mov_b64 s[52:53], s[24:25]
    s_mov_b32 s54, 0x00400000
    s_mov_b32 s55, 0x00020000
    v_and_b32 v4, 3, v3
    v_lshrrev_b32 v5, 2, v3
    v_xor_b32 v6, v4, v2
    v_mul_u32_u24 v9, 1040, v5
    v_lshl_add_u32 v9, v4, 8, v9
    v_lshl_add_u32 v9, v6, 6, v9
    v_add_u32 v9, s14, v9
    v_mul_u32_u24 v10, 1056, v2
    v_lshl_add_u32 v10, v5, 8, v10
    v_lshl_add_u32 v10, v4, 3, v10
    v_xor_b32 v6, s66, v5
    v_lshl_add_u32 v10, v6, 6, v10
    v_add_u32 v10, 45568, v10
    v_mul_u32_u24 v12, 272, v5
    v_lshl_add_u32 v12, v2, 6, v12
    v_lshlrev_b32 v15, 4, v5
    v_lshl_add_u32 v13, v2, 6, v15
    s_lshl_b32 s13, s66, 2
    s_add_u32 s13, s13, 2304
    v_add_u32 v14, s13, v15
    s_lshl_b32 s13, s66, 8
    v_lshl_add_u32 v197, v1, 2, s13
    v_lshlrev_b32 v8, 14, v5
    v_and_b32 v6, 1, v3
    v_lshl_add_u32 v8, v6, 4, v8
    v_lshrrev_b32 v6, 1, v2
    v_lshl_add_u32 v8, v6, 11, v8
    v_and_b32 v6, 1, v2
    v_lshl_add_u32 v8, v6, 5, v8
    s_lshl_b32 s84, s4, 16
    s_add_u32 s84, s84, 1048576
    s_and_b32 s13, s5, 28
    s_add_u32 s13, s13, s66
    s_lshl_b32 s13, s13, 11
    s_add_u32 s91, s84, s13
    s_lshl_b32 s13, s66, 12
    s_add_u32 s84, s84, s13
    s_lshl_b32 s13, s5, 6
    s_add_u32 s84, s84, s13
    v_lshlrev_b32 v38, 4, v1
    v_lshrrev_b32 v6, 1, v3
    v_lshlrev_b32 v41, 7, v6
    v_lshl_add_u32 v41, v2, 5, v41
    v_and_b32 v6, 1, v3
    v_lshl_add_u32 v41, v6, 4, v41
    v_mul_u32_u24 v11, 768, v2
    v_add_u32 v11, v11, v7
    s_mul_i32 s94, s66, 4224
    s_add_u32 s94, s94, 95744
    s_lshl_b32 s90, s4, 19
    s_lshr_b32 s8, s5, 2
    s_lshl_b32 s13, s8, 16
    s_add_u32 s90, s90, s13
    s_and_b32 s9, s5, 3
    s_lshl_b32 s13, s9, 8
    s_add_u32 s90, s90, s13
    s_lshl_b32 s13, s66, 14
    s_add_u32 s90, s90, s13
    s_lshl_b32 s92, s9, 16
    s_lshl_b32 s13, s4, 13
    s_add_u32 s92, s92, s13
    s_lshl_b32 s13, s8, 10
    s_add_u32 s92, s92, s13
    s_lshl_b32 s13, s66, 8
    s_add_u32 s92, s92, s13
    s_add_u32 s92, s92, 393216
    v_lshlrev_b32 v40, 4, v2
    s_lshl_b32 s13, s66, 5
    v_lshl_add_u32 v39, v4, 3, s13
    v_and_b32 v6, 1, v2
    v_lshl_add_u32 v39, v6, 2, v39
    v_lshrrev_b32 v6, 1, v2
    v_lshl_add_u32 v39, v6, 1, v39
    v_mov_b32 v20, 0x3f803f80
    v_mov_b32 v21, 0x3f803f80
    v_mov_b32 v22, 0x3f803f80
    v_mov_b32 v23, 0x3f803f80
    s_mov_b32 s68, 0x000f000f
    s_mov_b32 s69, 0x000f000f
    s_mov_b32 s72, 0xaaaaaaaa
    s_mov_b32 s73, 0xaaaaaaaa
    s_mov_b32 s74, 0xcccccccc
    s_mov_b32 s75, 0xcccccccc
    s_mov_b32 s70, 0x33333333
    s_mov_b32 s71, 0x33333333
    s_mov_b32 s76, 0x11111111
    s_mov_b32 s77, 0x11111111
    s_mov_b32 s8, 0x3db504f3
    s_mov_b32 s9, 0x3fb8aa3b
    v_mov_b32 v4, 2112
    s_lshl_b32 s13, s4, 16
    s_lshl_b32 s80, s5, 11
    s_add_u32 s13, s13, s80
    s_lshl_b32 s80, s66, 9
    s_add_u32 s13, s13, s80
    s_add_u32 s13, s13, 1048576
    s_mov_b32 exec_hi, 0
    buffer_load_dwordx4 v[64:67], v38, s[60:63], s13 offen nt
    s_mov_b64 exec, -1
    s_barrier
    s_mov_b32 s65, 4
L_kloop2:
    s_and_b32 s96, s96, 7
    s_mul_i32 s87, s96, 1040
    s_add_u32 m0, s87, s97
    s_lshl_b32 s87, s96, 10
    s_add_u32 s87, s87, s15
    s_add_u32 s96, s96, 1
    s_waitcnt vmcnt(3)
    buffer_load_dwordx4 v7, s[44:47], s87 offen nt lds
    s_sub_u32 s65, s65, 1
    s_cmp_lg_u32 s65, 0
    s_cbranch_scc1 L_kloop2
    s_mul_i32 s13, s66, 8448
    s_add_u32 m0, s13, 45568
    s_add_u32 s97, s13, 45568
    s_mov_b32 s65, 8
L_vloop:
    s_and_b32 s96, s96, 7
    s_mul_i32 s87, s96, 1056
    s_add_u32 m0, s87, s97
    s_lshl_b32 s87, s96, 10
    s_add_u32 s87, s87, s85
    s_add_u32 s96, s96, 1
    s_waitcnt vmcnt(5)
    buffer_load_dwordx4 v7, s[48:51], s87 offen nt lds
    s_sub_u32 s65, s65, 1
    s_cmp_lg_u32 s65, 0
    s_cbranch_scc1 L_vloop
    s_mov_b32 m0, s94
    s_waitcnt vmcnt(8) lgkmcnt(0)
    ds_read_b128 v[132:135], v9 offset:0
    ds_read_b128 v[136:139], v9 offset:16
    ds_read_b128 v[140:143], v9 offset:32
    ds_read_b128 v[144:147], v9 offset:48
    ds_read_b128 v[148:151], v9 offset:4160
    ds_read_b128 v[152:155], v9 offset:4176
    ds_read_b128 v[156:159], v9 offset:4192
    ds_read_b128 v[160:163], v9 offset:4208
    s_barrier
    ds_read_b128 v[116:119], v12 offset:1024
    ds_read_b128 v[120:123], v12 offset:1040
    ds_read_b128 v[124:127], v12 offset:1056
    ds_read_b128 v[128:131], v12 offset:1072
    ds_read_b64 v[62:63], v4
    s_waitcnt lgkmcnt(4)
    v_mfma_f32_16x16x32_bf16 v[24:27], v[132:135], v[116:119], 0
    v_mfma_f32_16x16x32_bf16 v[28:31], v[148:151], v[116:119], 0
    s_waitcnt lgkmcnt(3)
    v_mfma_f32_16x16x32_bf16 v[24:27], v[136:139], v[120:123], v[24:27]
    v_mfma_f32_16x16x32_bf16 v[28:31], v[152:155], v[120:123], v[28:31]
    s_waitcnt lgkmcnt(2)
    v_mfma_f32_16x16x32_bf16 v[24:27], v[140:143], v[124:127], v[24:27]
    v_mfma_f32_16x16x32_bf16 v[28:31], v[156:159], v[124:127], v[28:31]
    s_waitcnt lgkmcnt(1)
    v_mfma_f32_16x16x32_bf16 v[24:27], v[144:147], v[128:131], v[24:27]
    v_mfma_f32_16x16x32_bf16 v[28:31], v[160:163], v[128:131], v[28:31]
    s_waitcnt lgkmcnt(0)
    v_readfirstlane_b32 s67, v62
    v_readfirstlane_b32 s10, v63
    v_mov_b32 v62, v63
    v_mov_b32 v19, v63
    s_nop 2
    v_cndmask_b32 v24, v24, v26, s[72:73]
    v_cndmask_b32 v25, v25, v27, s[72:73]
    v_cndmask_b32 v28, v28, v30, s[72:73]
    v_cndmask_b32 v29, v29, v31, s[72:73]
    v_cndmask_b32 v24, v24, v28, s[74:75]
    v_cndmask_b32 v25, v25, v29, s[74:75]
    v_cvt_pk_bf16_f32 v32, v24, v25
    v_lshlrev_b32 v24, 16, v32
    v_and_b32 v25, 0xffff0000, v32
    v_mul_f32 v24, s8, v24
    v_mul_f32 v25, s8, v25
    v_cvt_pk_bf16_f32 v32, v24, v25
    v_lshlrev_b32 v24, 16, v32
    v_and_b32 v25, 0xffff0000, v32
    v_max_f32 v36, v24, v25
    s_nop 1
    v_max_f32_dpp v36, v36, v36 quad_perm:[1,0,3,2] row_mask:0xf bank_mask:0xf
    s_nop 1
    v_max_f32_dpp v36, v36, v36 quad_perm:[2,3,0,1] row_mask:0xf bank_mask:0xf
    v_mov_b32 v37, v36
    s_nop 1
    v_permlane32_swap_b32 v36, v37
    v_max_f32 v36, v36, v37
    v_mov_b32 v37, v36
    s_nop 1
    v_permlane16_swap_b32 v36, v37
    v_max_f32 v36, v36, v37
    v_mul_f32 v36, s9, v36
    ds_write_b32 v14, v36
    v_mul_f32 v24, s9, v24
    v_mul_f32 v25, s9, v25
    s_cmp_eq_u32 s67, 0
    s_cselect_b32 s86, 1048576, 0
    s_add_u32 s84, s84, s86
    s_add_u32 s91, s91, s86
    s_waitcnt lgkmcnt(0)
    s_barrier
    ds_read_b128 v[44:47], v15 offset:2304
    s_waitcnt lgkmcnt(0)
    v_max3_f32 v36, v44, v45, v46
    v_max_f32 v36, v36, v47
    v_sub_f32 v24, v24, v36
    v_sub_f32 v25, v25, v36
    v_exp_f32 v24, v24
    v_exp_f32 v25, v25
    s_nop 0
    v_cvt_pk_bf16_f32 v32, v24, v25
    ds_write_b32 v197, v32 offset:2560
    buffer_load_dwordx4 v11, s[52:55], s90 offen offset:0 nt lds
    s_add_u32 s90, s90, 3040
    buffer_load_dwordx4 v11, s[52:55], s90 offen offset:1056 nt lds
    s_add_u32 s90, s90, 3040
    buffer_load_dwordx4 v11, s[52:55], s90 offen offset:2112 nt lds
    s_add_u32 s90, s90, 3040
    buffer_load_dwordx4 v11, s[52:55], s90 offen offset:3168 nt lds
    s_waitcnt lgkmcnt(0)
    s_barrier
    ds_read_b128 v[116:119], v13 offset:2560
    ds_read_b128 v[120:123], v13 offset:2816
    ds_read_b128 v[124:127], v13 offset:3072
    ds_read_b128 v[128:131], v13 offset:3328
    s_waitcnt lgkmcnt(3)
    v_mfma_f32_16x16x32_bf16 v[96:99], v[20:23], v[116:119], 0
    s_waitcnt lgkmcnt(2)
    v_mfma_f32_16x16x32_bf16 v[96:99], v[20:23], v[120:123], v[96:99]
    s_waitcnt lgkmcnt(1)
    v_mfma_f32_16x16x32_bf16 v[96:99], v[20:23], v[124:127], v[96:99]
    s_waitcnt lgkmcnt(0)
    v_mfma_f32_16x16x32_bf16 v[96:99], v[20:23], v[128:131], v[96:99]
    s_waitcnt vmcnt(4)
    s_barrier
    ds_read_b64_tr_b16 v[164:165], v10 offset:0
    ds_read_b64_tr_b16 v[166:167], v10 offset:4224
    ds_read_b64_tr_b16 v[168:169], v10 offset:32
    ds_read_b64_tr_b16 v[170:171], v10 offset:4256
    ds_read_b64_tr_b16 v[172:173], v10 offset:8448
    ds_read_b64_tr_b16 v[174:175], v10 offset:12672
    ds_read_b64_tr_b16 v[176:177], v10 offset:8480
    ds_read_b64_tr_b16 v[178:179], v10 offset:12704
    ds_read_b64_tr_b16 v[180:181], v10 offset:16896
    ds_read_b64_tr_b16 v[182:183], v10 offset:21120
    ds_read_b64_tr_b16 v[184:185], v10 offset:16928
    ds_read_b64_tr_b16 v[186:187], v10 offset:21152
    ds_read_b64_tr_b16 v[188:189], v10 offset:25344
    ds_read_b64_tr_b16 v[190:191], v10 offset:29568
    ds_read_b64_tr_b16 v[192:193], v10 offset:25376
    ds_read_b64_tr_b16 v[194:195], v10 offset:29600
    v_rcp_f32 v42, v96
    v_log_f32 v43, v96
    s_waitcnt lgkmcnt(14)
    v_mfma_f32_16x16x32_bf16 v[64:67], v[164:167], v[116:119], 0
    s_waitcnt lgkmcnt(12)
    v_mfma_f32_16x16x32_bf16 v[68:71], v[168:171], v[116:119], 0
    s_waitcnt lgkmcnt(10)
    v_mfma_f32_16x16x32_bf16 v[64:67], v[172:175], v[120:123], v[64:67]
    s_waitcnt lgkmcnt(8)
    v_mfma_f32_16x16x32_bf16 v[68:71], v[176:179], v[120:123], v[68:71]
    s_waitcnt lgkmcnt(6)
    v_mfma_f32_16x16x32_bf16 v[64:67], v[180:183], v[124:127], v[64:67]
    s_waitcnt lgkmcnt(4)
    v_mfma_f32_16x16x32_bf16 v[68:71], v[184:187], v[124:127], v[68:71]
    s_waitcnt lgkmcnt(2)
    v_mfma_f32_16x16x32_bf16 v[64:67], v[188:191], v[128:131], v[64:67]
    s_waitcnt lgkmcnt(0)
    v_mfma_f32_16x16x32_bf16 v[68:71], v[192:195], v[128:131], v[68:71]
    v_add_f32 v18, v36, v43
    s_nop 6
    v_cndmask_b32 v52, v64, v68, s[72:73]
    v_cndmask_b32 v53, v65, v69, s[72:73]
    v_cndmask_b32 v54, v66, v70, s[72:73]
    v_cndmask_b32 v55, v67, v71, s[72:73]
    v_mul_f32 v52, v52, v42
    v_mul_f32 v53, v53, v42
    v_mul_f32 v54, v54, v42
    v_mul_f32 v55, v55, v42
    v_cvt_pk_bf16_f32 v16, v52, v53
    v_cvt_pk_bf16_f32 v17, v54, v55
    s_mov_b64 exec, s[70:71]
    s_cmp_eq_u32 s67, 0
    s_cbranch_scc1 L_p2slow
    buffer_store_dwordx4 v[16:19], v8, s[60:63], s84 offen
L_p2done:
    s_mov_b64 exec, -1
    s_waitcnt vmcnt(3)
    buffer_load_dwordx4 v[132:135], v38, s[60:63], s91 offen offset:0 sc1
    buffer_load_dwordx4 v[136:139], v38, s[60:63], s91 offen offset:1024 sc1
    s_branch L_h2chk
L_h2retry:
    s_not_b64 exec, exec
    buffer_load_dwordx4 v[132:135], v38, s[60:63], s91 offen offset:0 sc1
    buffer_load_dwordx4 v[136:139], v38, s[60:63], s91 offen offset:1024 sc1
    s_mov_b64 exec, -1
L_h2chk:
    s_waitcnt vmcnt(0)
L_h2chk2:
    v_cmpx_eq_u32 vcc, s10, v135
    v_cmpx_eq_u32 vcc, s10, v139
    s_cmp_eq_u64 exec, -1
    s_cbranch_scc1 L_h2ok
    s_sub_u32 s12, s12, 1
    s_cbranch_scc0 L_h2retry
    s_branch L_end
L_h2ok:
    v_max_f32 v36, v134, v138
    v_lshlrev_b32 v164, 16, v132
    v_and_b32 v165, 0xffff0000, v132
    v_mov_b32 v37, v36
    v_lshlrev_b32 v166, 16, v133
    v_and_b32 v167, 0xffff0000, v133
    v_permlane32_swap_b32 v36, v37
    v_max_f32 v36, v36, v37
    v_mov_b32 v37, v36
    v_lshlrev_b32 v168, 16, v136
    v_and_b32 v169, 0xffff0000, v136
    v_permlane16_swap_b32 v36, v37
    v_max_f32 v36, v36, v37
    v_lshlrev_b32 v170, 16, v137
    v_and_b32 v171, 0xffff0000, v137
    v_max_f32_dpp v36, v36, v36 row_ror:8 row_mask:0xf bank_mask:0xf
    s_nop 1
    v_max_f32_dpp v36, v36, v36 row_ror:4 row_mask:0xf bank_mask:0xf
    v_sub_f32 v44, v134, v36
    v_sub_f32 v45, v138, v36
    v_exp_f32 v44, v44
    v_exp_f32 v45, v45
    v_mul_f32 v52, v44, v164
    v_add_f32 v56, v44, v45
    v_add_f32 v57, v44, v45
    v_mul_f32 v53, v44, v165
    v_mul_f32 v54, v44, v166
    v_mul_f32 v55, v44, v167
    v_permlane32_swap_b32 v56, v57
    v_fmac_f32 v52, v45, v168
    v_fmac_f32 v53, v45, v169
    v_add_f32 v42, v56, v57
    v_add_f32 v43, v56, v57
    v_fmac_f32 v54, v45, v170
    v_fmac_f32 v55, v45, v171
    v_permlane32_swap_b32 v52, v53
    v_permlane16_swap_b32 v42, v43
    v_permlane32_swap_b32 v54, v55
    v_add_f32 v52, v52, v53
    v_add_f32 v54, v54, v55
    v_add_f32 v56, v42, v43
    s_nop 0
    v_permlane16_swap_b32 v52, v54
    v_add_f32_dpp v56, v56, v56 row_ror:8 row_mask:0xf bank_mask:0xf
    v_add_f32 v52, v52, v54
    s_nop 0
    v_add_f32_dpp v56, v56, v56 row_ror:4 row_mask:0xf bank_mask:0xf
    v_add_f32_dpp v52, v52, v52 row_ror:8 row_mask:0xf bank_mask:0xf
    v_rcp_f32 v56, v56
    s_nop 0
    v_add_f32_dpp v52, v52, v52 row_ror:4 row_mask:0xf bank_mask:0xf
    v_mul_f32 v52, v52, v56
    v_cvt_pk_bf16_f32 v52, v52, v52
    s_mov_b64 exec, s[68:69]
    ds_write_b16 v39, v52 offset:2176
    s_mov_b64 exec, -1
    s_waitcnt vmcnt(0) lgkmcnt(0)
    s_barrier
    ds_read_b128 v[44:47], v40 offset:2176
    ds_read_b64_tr_b16 v[100:101], v10 offset:50176
    ds_read_b64_tr_b16 v[102:103], v10 offset:54400
    ds_read_b64_tr_b16 v[108:109], v10 offset:50208
    ds_read_b64_tr_b16 v[110:111], v10 offset:54432
    ds_read_b128 v[48:51], v40 offset:2240
    ds_read_b64_tr_b16 v[104:105], v10 offset:58624
    ds_read_b64_tr_b16 v[106:107], v10 offset:62848
    ds_read_b64_tr_b16 v[112:113], v10 offset:58656
    ds_read_b64_tr_b16 v[114:115], v10 offset:62880
    s_waitcnt lgkmcnt(7)
    v_mfma_f32_16x16x32_bf16 v[24:27], v[100:103], v[44:47], 0
    s_waitcnt lgkmcnt(5)
    v_mfma_f32_16x16x32_bf16 v[28:31], v[108:111], v[44:47], 0
    s_waitcnt lgkmcnt(2)
    v_mfma_f32_16x16x32_bf16 v[24:27], v[104:107], v[48:51], v[24:27]
    s_waitcnt lgkmcnt(0)
    v_mfma_f32_16x16x32_bf16 v[28:31], v[112:115], v[48:51], v[28:31]
    s_nop 6
    v_cndmask_b32 v52, v24, v26, s[72:73]
    v_cndmask_b32 v53, v25, v27, s[72:73]
    v_cndmask_b32 v54, v28, v30, s[72:73]
    v_cndmask_b32 v55, v29, v31, s[72:73]
    v_cndmask_b32 v60, v52, v54, s[74:75]
    v_cndmask_b32 v61, v53, v55, s[74:75]
    s_mov_b64 exec, s[68:69]
    buffer_store_dwordx4 v[60:63], v41, s[60:63], s92 offen sc1
    s_mov_b64 exec, -1
L_fin:
L_fin2:
L_end:
    s_endpgm
L_p2slow:
    buffer_store_dwordx4 v[16:19], v8, s[60:63], s84 offen sc1
    s_branch L_p2done
L_codeend:
.section .rodata,"a"
.p2align 6
.amdhsa_kernel recurrent_scan__sliding_block_cached__mixer_token_mlp__decode_kernel
  .amdhsa_next_free_vgpr 256
  .amdhsa_next_free_sgpr 102
  .amdhsa_accum_offset 256
  .amdhsa_group_segment_fixed_size 0
  .amdhsa_kernarg_size 104
  .amdhsa_user_sgpr_count 2
  .amdhsa_user_sgpr_kernarg_segment_ptr 1
  .amdhsa_system_sgpr_workgroup_id_x 1
  .amdhsa_float_denorm_mode_32 3
.end_amdhsa_kernel
```
